```python
import torch

def _softmax(x, axis=-1):
    return torch.softmax(x, dim=axis)
def _gelu(x):
    return torch.nn.functional.gelu(x, approximate="tanh")
def _silu(x):
    return torch.nn.functional.silu(x)
def _sigmoid(x):
    return torch.sigmoid(x)
def _layernorm(x, axis=-1, eps=1e-5):
    m = x.mean(dim=axis, keepdim=True)
    v = x.var(dim=axis, keepdim=True, unbiased=False)
    return (x - m) / torch.sqrt(v + eps)
def _scatter_add(tgt, idx, src, axis=0):
    return tgt.clone().index_add_(axis, idx, src)
def _segment_sum(src, seg, n):
    out = torch.zeros((n,) + src.shape[1:], dtype=src.dtype)
    return out.index_add_(0, seg, src)
def _pad(x, pw):
    flat = tuple(v for pair in reversed(pw) for v in pair)
    return torch.nn.functional.pad(x, flat)

kernel_name = 'standalone__glu_gated_glu__decode'

def setup_inputs():

    _w = (lambda a: (lambda t: t.to(torch.bfloat16) if t.is_floating_point() else t)(torch.as_tensor(a)))
    B, S, D, F = 1, 1, 1024, 3584
    return {
        "x": _w((lambda *s: torch.randn(*s, dtype=torch.bfloat16) * 0.1)(B, S, D)),
        "w_gate": _w((lambda *s: torch.randn(*s, dtype=torch.bfloat16) * 0.1)(D, F)),
        "w_up": _w((lambda *s: torch.randn(*s, dtype=torch.bfloat16) * 0.05)(D, F)),
        "w_down": _w((lambda *s: torch.randn(*s, dtype=torch.bfloat16) * 0.05)(F, D)),
    }

def reference(x, w_gate, w_up, w_down):
    g = torch.einsum("bsd,df->bsf", x, w_gate)
    u = torch.einsum("bsd,df->bsf", x, w_up)
    h = _sigmoid(g) * u
    return torch.einsum("bsf,fd->bsd", h, w_down)
```

```asm
; @launch grid=(256,1,1) block=(256,1,1) lds=64
.amdgcn_target "amdgcn-amd-amdhsa--gfx950"
.text
.globl standalone__glu_gated_glu__decode_kernel
.p2align 12
.p2align 8
.type standalone__glu_gated_glu__decode_kernel,@function
standalone__glu_gated_glu__decode_kernel:
    s_load_dwordx2 s[4:5], s[0:1], 0
    s_load_dwordx4 s[12:15], s[0:1], 8
    s_load_dwordx2 s[24:25], s[0:1], 48
    v_readfirstlane_b32 s40, v0
    s_cmpk_ge_u32 s2, 224
    s_cbranch_scc1 L_cons0
    v_bfe_u32 v194, v0, 3, 4
    v_and_b32 v196, 7, v0
    v_mul_u32_u24 v1, 114688, v194
    v_lshl_add_u32 v1, v196, 4, v1
    v_and_b32 v193, 1, v0
    v_bfi_b32 v2, 1, v0, v194
    v_lshlrev_b32 v2, 5, v2
    s_lshr_b32 s42, s2, 5
    s_lshr_b32 s3, s40, 5
    s_add_u32 s38, s42, s3
    s_sub_u32 s3, s38, 7
    s_cselect_b32 s38, s38, s3
    s_and_b32 s39, s2, 7
    s_mulk_i32 s39, 7
    s_add_u32 s38, s38, s39
    s_bfe_u32 s43, s2, 0x20003
    s_mul_i32 s28, s43, 1835008
    s_lshl_b32 s3, s38, 7
    s_add_u32 s28, s28, s3
    s_lshl_b32 s29, s43, 9
    s_movk_i32 s6, 2048
    s_mov_b32 s7, 0x20000
    s_mov_b32 s10, 7340032
    s_mov_b32 s11, s7
    s_bitcmp1_b32 s40, 7
    s_waitcnt lgkmcnt(0)
    s_cselect_b64 s[8:9], s[14:15], s[12:13]
    buffer_load_dwordx4 v[84:87], v1, s[8:11], s28 offen nt
    s_addk_i32 s28, 7168
    buffer_load_dwordx4 v[88:91], v1, s[8:11], s28 offen nt
    s_addk_i32 s28, 7168
    buffer_load_dwordx4 v[8:11], v2, s[4:7], s29 offen
    buffer_load_dwordx4 v[12:15], v2, s[4:7], s29 offen offset:16
    s_load_dwordx2 s[16:17], s[0:1], 24
    s_load_dword s41, s[24:25], 0
    buffer_load_dwordx4 v[92:95], v1, s[8:11], s28 offen nt
    s_addk_i32 s28, 7168
    buffer_load_dwordx4 v[96:99], v1, s[8:11], s28 offen nt
    s_addk_i32 s28, 7168
    buffer_load_dwordx4 v[100:103], v1, s[8:11], s28 offen nt
    s_addk_i32 s28, 7168
    buffer_load_dwordx4 v[104:107], v1, s[8:11], s28 offen nt
    s_addk_i32 s28, 7168
    buffer_load_dwordx4 v[108:111], v1, s[8:11], s28 offen nt
    s_addk_i32 s28, 7168
    buffer_load_dwordx4 v[112:115], v1, s[8:11], s28 offen nt
    s_addk_i32 s28, 7168
    buffer_load_dwordx4 v[116:119], v1, s[8:11], s28 offen nt
    s_addk_i32 s28, 7168
    buffer_load_dwordx4 v[120:123], v1, s[8:11], s28 offen nt
    s_addk_i32 s28, 7168
    buffer_load_dwordx4 v[124:127], v1, s[8:11], s28 offen nt
    s_addk_i32 s28, 7168
    buffer_load_dwordx4 v[128:131], v1, s[8:11], s28 offen nt
    s_addk_i32 s28, 7168
    buffer_load_dwordx4 v[132:135], v1, s[8:11], s28 offen nt
    s_addk_i32 s28, 7168
    buffer_load_dwordx4 v[136:139], v1, s[8:11], s28 offen nt
    s_addk_i32 s28, 7168
    buffer_load_dwordx4 v[140:143], v1, s[8:11], s28 offen nt
    s_addk_i32 s28, 7168
    buffer_load_dwordx4 v[144:147], v1, s[8:11], s28 offen nt
    s_branch L_w1
L_cons0:
    s_cmpk_ge_u32 s2, 256
    s_cbranch_scc1 L_end
    s_load_dwordx2 s[16:17], s[0:1], 40
    s_mov_b32 s26, 1028096
    s_mov_b32 s27, 0x20000
    s_movk_i32 s18, 256
    s_mov_b32 s19, s27
    s_cmp_lg_u32 s40, 0
    s_cbranch_scc1 L_cons
    s_lshl_b32 s48, s2, 14
    s_add_u32 s30, s48, 4291779584
    s_add_u32 s31, s30, 8192
    s_mov_b64 exec, 1
    s_waitcnt lgkmcnt(0)
    buffer_store_dword v0, v0, s[24:27], s30 offen sc1
    buffer_store_dword v0, v0, s[24:27], s31 offen sc1
    s_waitcnt vmcnt(1)
    s_memtime s[32:33]
    s_waitcnt vmcnt(0)
    s_memtime s[28:29]
    s_waitcnt lgkmcnt(0)
    s_sub_u32 s28, s28, s32
    s_cmp_lt_u32 s28, 50
    s_cselect_b32 s34, 1, -1
    s_getreg_b32 s35, hwreg(HW_REG_XCC_ID, 2, 1)
    s_sub_u32 s35, 0, s35
    s_or_b32 s35, s35, 1
    s_mul_i32 s34, s34, s35
    s_lshl_b32 s3, s2, 2
    s_sub_u32 s3, s3, 768
    v_mov_b32 v194, s34
    buffer_store_dword v194, v0, s[16:19], s3 offen sc1
    s_mov_b64 exec, -1
    s_branch L_cons
L_w1:
    s_add_u32 s42, s42, s39
    s_lshr_b32 s40, s40, 6
    v_bfe_u32 v194, v0, 3, 3
    v_lshlrev_b32 v3, 14, v194
    v_lshl_add_u32 v3, v196, 4, v3
    s_lshl_b32 s30, s42, 17
    s_add_u32 s30, s30, s29
    s_lshl_b32 s3, s40, 7
    s_add_u32 s30, s30, s3
    s_mov_b32 s18, s10
    s_mov_b32 s19, s7
    s_mov_b32 s26, 1028096
    s_mov_b32 s27, s7
    s_waitcnt lgkmcnt(0)
    buffer_load_dwordx4 v[148:151], v3, s[16:19], s30 offen nt
    s_addk_i32 s30, 2048
    buffer_load_dwordx4 v[152:155], v3, s[16:19], s30 offen nt
    s_addk_i32 s30, 2048
    v_bfe_u32 v194, v0, 4, 2
    v_lshlrev_b32 v198, 3, v196
    v_lshl_add_u32 v198, v194, 6, v198
    s_lshr_b32 s56, s40, 1
    s_lshl_b32 s56, s56, 2
    s_add_u32 s56, s56, s43
    s_lshl_b32 s56, s56, 1
    s_and_b32 s57, s40, 1
    s_add_u32 s56, s56, s57
    s_lshl_b32 s56, s56, 8
    s_lshl_b32 s57, s38, 12
    s_add_u32 s56, s56, s57
    s_add_u32 s44, s56, 16384
    s_add_u32 s54, s56, 245760
    s_mov_b32 s58, 0x00ff00ff
    s_mov_b32 s59, s58
    v_lshl_add_u32 v201, v194, 1, v193
    v_lshlrev_b32 v201, 4, v201
    s_lshl_b32 s13, s42, 8
    s_add_u32 s45, s13, 999424
    s_add_u32 s55, s13, 1013760
    s_xor_b32 s55, s55, s45
    s_mov_b32 s31, 0
    v_and_b32 v195, 3, v0
    v_lshlrev_b32 v197, 3, v195
    v_lshlrev_b32 v202, 5, v195
    v_bfe_u32 v195, v0, 4, 1
    v_lshl_add_u32 v202, v195, 4, v202
    v_bfe_u32 v195, v0, 5, 1
    v_lshl_add_u32 v202, v195, 13, v202
    v_bfe_u32 v195, v0, 2, 1
    v_lshl_add_u32 v202, v195, 14, v202
    s_lshl_b32 s13, s43, 2
    s_add_u32 s13, s13, s40
    s_lshl_b32 s13, s13, 15
    s_lshl_b32 s15, s42, 7
    s_add_u32 s13, s13, s15
    s_add_u32 s46, s13, 475136
    v_bfe_u32 v195, v0, 1, 1
    v_lshlrev_b32 v195, 4, v195
    v_mov_b32 v193, 0xffff
    v_lshlrev_b32 v195, v195, v193
    v_bfe_u32 v193, v0, 2, 2
    v_cmp_eq_u32 vcc, 0, v193
    s_nop 1
    v_cndmask_b32 v4, 0, v195, vcc
    v_cmp_eq_u32 vcc, 1, v193
    s_nop 1
    v_cndmask_b32 v5, 0, v195, vcc
    v_cmp_eq_u32 vcc, 2, v193
    s_nop 1
    v_cndmask_b32 v6, 0, v195, vcc
    v_cmp_eq_u32 vcc, 3, v193
    s_nop 1
    v_cndmask_b32 v7, 0, v195, vcc
    s_mov_b32 s50, 0x01000100
    s_mov_b32 s51, 0x03020302
    s_mov_b32 s52, 0xffffff00
    s_mov_b32 s53, 0xffff
    s_mov_b32 s32, 0x05040100
    s_mov_b32 s33, 0x07060302
    s_add_u32 s41, s41, 0x9e3779b1
    v_lshrrev_b32 v195, v197, s41
    v_and_b32 v188, 15, v195
    v_bfe_u32 v189, v195, 4, 4
    v_bfe_u32 v204, s41, 0, 8
    v_bfe_u32 v205, s41, 8, 8
    v_bfe_u32 v206, s41, 16, 8
    v_bfe_u32 v207, s41, 24, 8
    s_waitcnt vmcnt(16)
    v_perm_b32 v195, v8, v8, s50
    v_and_b32 v20, v195, v4
    v_and_b32 v21, v195, v5
    v_and_b32 v22, v195, v6
    v_and_b32 v23, v195, v7
    v_perm_b32 v195, v8, v8, s51
    v_and_b32 v24, v195, v4
    v_and_b32 v25, v195, v5
    v_and_b32 v26, v195, v6
    v_and_b32 v27, v195, v7
    v_perm_b32 v195, v9, v9, s50
    v_and_b32 v28, v195, v4
    v_and_b32 v29, v195, v5
    v_and_b32 v30, v195, v6
    v_and_b32 v31, v195, v7
    v_perm_b32 v195, v9, v9, s51
    v_and_b32 v32, v195, v4
    v_and_b32 v33, v195, v5
    v_and_b32 v34, v195, v6
    v_and_b32 v35, v195, v7
    v_perm_b32 v195, v10, v10, s50
    v_and_b32 v36, v195, v4
    v_and_b32 v37, v195, v5
    v_and_b32 v38, v195, v6
    v_and_b32 v39, v195, v7
    v_perm_b32 v195, v10, v10, s51
    v_and_b32 v40, v195, v4
    v_and_b32 v41, v195, v5
    v_and_b32 v42, v195, v6
    v_and_b32 v43, v195, v7
    v_perm_b32 v195, v11, v11, s50
    v_and_b32 v44, v195, v4
    v_and_b32 v45, v195, v5
    v_and_b32 v46, v195, v6
    v_and_b32 v47, v195, v7
    v_perm_b32 v195, v11, v11, s51
    v_and_b32 v48, v195, v4
    v_and_b32 v49, v195, v5
    v_and_b32 v50, v195, v6
    v_and_b32 v51, v195, v7
    v_perm_b32 v195, v12, v12, s50
    v_and_b32 v52, v195, v4
    v_and_b32 v53, v195, v5
    v_and_b32 v54, v195, v6
    v_and_b32 v55, v195, v7
    v_perm_b32 v195, v12, v12, s51
    v_and_b32 v56, v195, v4
    v_and_b32 v57, v195, v5
    v_and_b32 v58, v195, v6
    v_and_b32 v59, v195, v7
    v_perm_b32 v195, v13, v13, s50
    v_and_b32 v60, v195, v4
    v_and_b32 v61, v195, v5
    v_and_b32 v62, v195, v6
    v_and_b32 v63, v195, v7
    v_perm_b32 v195, v13, v13, s51
    v_and_b32 v64, v195, v4
    v_and_b32 v65, v195, v5
    v_and_b32 v66, v195, v6
    v_and_b32 v67, v195, v7
    v_perm_b32 v195, v14, v14, s50
    v_and_b32 v68, v195, v4
    v_and_b32 v69, v195, v5
    v_and_b32 v70, v195, v6
    v_and_b32 v71, v195, v7
    v_perm_b32 v195, v14, v14, s51
    v_and_b32 v72, v195, v4
    v_and_b32 v73, v195, v5
    v_and_b32 v74, v195, v6
    v_and_b32 v75, v195, v7
    v_perm_b32 v195, v15, v15, s50
    v_and_b32 v76, v195, v4
    v_and_b32 v77, v195, v5
    v_and_b32 v78, v195, v6
    v_and_b32 v79, v195, v7
    v_perm_b32 v195, v15, v15, s51
    v_and_b32 v80, v195, v4
    v_and_b32 v81, v195, v5
    v_and_b32 v82, v195, v6
    v_and_b32 v83, v195, v7
    v_mfma_f32_16x16x32_bf16 v[180:183], v[20:23], v[84:87], 0
    v_mfma_f32_16x16x32_bf16 v[180:183], v[24:27], v[88:91], v[180:183]
    s_waitcnt vmcnt(15)
    v_mfma_f32_16x16x32_bf16 v[180:183], v[28:31], v[92:95], v[180:183]
    s_waitcnt vmcnt(14)
    v_mfma_f32_16x16x32_bf16 v[180:183], v[32:35], v[96:99], v[180:183]
    s_waitcnt vmcnt(13)
    v_mfma_f32_16x16x32_bf16 v[180:183], v[36:39], v[100:103], v[180:183]
    s_waitcnt vmcnt(12)
    v_mfma_f32_16x16x32_bf16 v[180:183], v[40:43], v[104:107], v[180:183]
    s_waitcnt vmcnt(11)
    v_mfma_f32_16x16x32_bf16 v[180:183], v[44:47], v[108:111], v[180:183]
    s_waitcnt vmcnt(10)
    v_mfma_f32_16x16x32_bf16 v[180:183], v[48:51], v[112:115], v[180:183]
    s_waitcnt vmcnt(9)
    v_mfma_f32_16x16x32_bf16 v[180:183], v[52:55], v[116:119], v[180:183]
    s_waitcnt vmcnt(8)
    v_mfma_f32_16x16x32_bf16 v[180:183], v[56:59], v[120:123], v[180:183]
    s_waitcnt vmcnt(7)
    v_mfma_f32_16x16x32_bf16 v[180:183], v[60:63], v[124:127], v[180:183]
    s_waitcnt vmcnt(6)
    v_mfma_f32_16x16x32_bf16 v[180:183], v[64:67], v[128:131], v[180:183]
    s_waitcnt vmcnt(5)
    v_mfma_f32_16x16x32_bf16 v[180:183], v[68:71], v[132:135], v[180:183]
    s_waitcnt vmcnt(4)
    v_mfma_f32_16x16x32_bf16 v[180:183], v[72:75], v[136:139], v[180:183]
    s_waitcnt vmcnt(3)
    v_mfma_f32_16x16x32_bf16 v[180:183], v[76:79], v[140:143], v[180:183]
    s_waitcnt vmcnt(2)
    v_mfma_f32_16x16x32_bf16 v[180:183], v[80:83], v[144:147], v[180:183]
    s_nop 7
    v_add_f32_dpp v16, v181, v180 row_ror:8 row_mask:0xf bank_mask:0xf
    v_add_f32_dpp v17, v183, v182 row_ror:8 row_mask:0xf bank_mask:0xf
    s_mov_b64 exec, s[58:59]
    v_add_u32 v16, 8, v16
    v_add_u32 v17, 8, v17
    v_and_or_b32 v16, v16, -16, v188
    v_and_or_b32 v17, v17, -16, v189
    buffer_store_dwordx2 v[16:17], v198, s[24:27], s44 offen
    s_mov_b64 exec, -1
    s_barrier
    buffer_load_dwordx4 v[156:159], v3, s[16:19], s30 offen nt
    s_addk_i32 s30, 2048
    buffer_load_dwordx4 v[160:163], v3, s[16:19], s30 offen nt
    s_addk_i32 s30, 2048
    buffer_load_dwordx4 v[164:167], v3, s[16:19], s30 offen nt
    s_addk_i32 s30, 2048
    buffer_load_dwordx4 v[168:171], v3, s[16:19], s30 offen nt
    s_addk_i32 s30, 2048
    buffer_load_dwordx4 v[172:175], v3, s[16:19], s30 offen nt
    s_addk_i32 s30, 2048
    buffer_load_dwordx4 v[176:179], v3, s[16:19], s30 offen nt
    s_mov_b32 s49, 1048576
    s_waitcnt vmcnt(6)
    v_perm_b32 v84, v152, v148, s32
    v_perm_b32 v88, v152, v148, s33
    v_perm_b32 v92, v153, v149, s32
    v_perm_b32 v96, v153, v149, s33
    v_perm_b32 v100, v154, v150, s32
    v_perm_b32 v104, v154, v150, s33
    v_perm_b32 v108, v155, v151, s32
    v_perm_b32 v112, v155, v151, s33
    s_waitcnt vmcnt(4)
    v_perm_b32 v85, v160, v156, s32
    v_perm_b32 v89, v160, v156, s33
    v_perm_b32 v93, v161, v157, s32
    v_perm_b32 v97, v161, v157, s33
    v_perm_b32 v101, v162, v158, s32
    v_perm_b32 v105, v162, v158, s33
    v_perm_b32 v109, v163, v159, s32
    v_perm_b32 v113, v163, v159, s33
    s_waitcnt vmcnt(3)
    buffer_load_dwordx4 v[116:119], v201, s[24:27], s45 offen sc1
    buffer_load_dwordx4 v[120:123], v201, s[24:27], s45 offen offset:128 sc1
    s_waitcnt vmcnt(4)
    v_perm_b32 v86, v168, v164, s32
    v_perm_b32 v90, v168, v164, s33
    v_perm_b32 v94, v169, v165, s32
    v_perm_b32 v98, v169, v165, s33
    v_perm_b32 v102, v170, v166, s32
    v_perm_b32 v106, v170, v166, s33
    v_perm_b32 v110, v171, v167, s32
    v_perm_b32 v114, v171, v167, s33
    s_waitcnt vmcnt(2)
    v_perm_b32 v87, v176, v172, s32
    v_perm_b32 v103, v178, v174, s32
L_p1:
    s_waitcnt vmcnt(1)
    v_xor_b32 v195, s41, v116
    v_perm_b32 v8, v117, v116, s32
    v_perm_b32 v9, v119, v118, s32
    s_waitcnt vmcnt(0)
    v_perm_b32 v10, v121, v120, s32
    v_perm_b32 v11, v123, v122, s32
    v_bitop3_b32 v195, v120, s41, v195 bitop3:0xbe
    v_cmp_lt_u32 vcc, s53, v195
    v_mfma_f32_16x16x32_bf16 v[20:23], v[8:11], v[84:87], 0
    s_cbranch_vccnz L_retry
    v_perm_b32 v91, v176, v172, s33
    v_bitop3_b32 v195, v117, s41, v195 bitop3:0xbe
    v_mfma_f32_16x16x32_bf16 v[36:39], v[8:11], v[100:103], 0
    v_perm_b32 v107, v178, v174, s33
    v_bitop3_b32 v195, v118, s41, v195 bitop3:0xbe
    v_mfma_f32_16x16x32_bf16 v[24:27], v[8:11], v[88:91], 0
    v_perm_b32 v95, v177, v173, s32
    v_bitop3_b32 v195, v119, s41, v195 bitop3:0xbe
    v_mfma_f32_16x16x32_bf16 v[40:43], v[8:11], v[104:107], 0
    v_perm_b32 v111, v179, v175, s32
    v_bitop3_b32 v195, v121, s41, v195 bitop3:0xbe
    v_mfma_f32_16x16x32_bf16 v[28:31], v[8:11], v[92:95], 0
    v_perm_b32 v99, v177, v173, s33
    v_bitop3_b32 v195, v122, s41, v195 bitop3:0xbe
    v_mfma_f32_16x16x32_bf16 v[44:47], v[8:11], v[108:111], 0
    v_perm_b32 v115, v179, v175, s33
    v_bitop3_b32 v195, v123, s41, v195 bitop3:0xbe
    v_mfma_f32_16x16x32_bf16 v[32:35], v[8:11], v[96:99], 0
    v_cmp_lt_u32 vcc, s53, v195
    v_add_f32_dpp v184, v21, v20 row_ror:8 row_mask:0x5 bank_mask:0xf
    v_add_f32_dpp v184, v37, v36 row_ror:8 row_mask:0xa bank_mask:0xf
    v_mfma_f32_16x16x32_bf16 v[48:51], v[8:11], v[112:115], 0
    s_cbranch_vccnz L_retry
L_go:
    v_add_f32_dpp v185, v25, v24 row_ror:8 row_mask:0x5 bank_mask:0xf
    v_add_f32_dpp v185, v41, v40 row_ror:8 row_mask:0xa bank_mask:0xf
    v_and_or_b32 v184, v184, s52, v204
    v_add_f32_dpp v186, v29, v28 row_ror:8 row_mask:0x5 bank_mask:0xf
    v_add_f32_dpp v186, v45, v44 row_ror:8 row_mask:0xa bank_mask:0xf
    v_and_or_b32 v185, v185, s52, v205
    v_add_f32_dpp v187, v33, v32 row_ror:8 row_mask:0x5 bank_mask:0xf
    v_add_f32_dpp v187, v49, v48 row_ror:8 row_mask:0xa bank_mask:0xf
    v_and_or_b32 v186, v186, s52, v206
    s_mov_b64 exec, s[58:59]
    v_and_or_b32 v187, v187, s52, v207
    buffer_store_dwordx4 v[184:187], v202, s[24:27], s46 offen sc1
    buffer_store_dwordx2 v[16:17], v198, s[24:27], s54 offen sc1
    s_endpgm
L_retry:
    s_cmp_eq_u32 s49, 1048564
    s_cbranch_scc1 L_slow
L_r2:
    s_xor_b32 s45, s45, s31
    buffer_load_dwordx4 v[116:119], v201, s[24:27], s45 offen sc1
    buffer_load_dwordx4 v[120:123], v201, s[24:27], s45 offen offset:128 sc1
    s_sub_u32 s49, s49, 1
    s_cbranch_scc0 L_p1
    s_waitcnt vmcnt(0)
    s_branch L_go
L_slow:
    s_mov_b64 exec, s[58:59]
    buffer_store_dwordx2 v[16:17], v198, s[24:27], s54 offen sc1
    s_mov_b64 exec, -1
    s_mov_b32 s31, s55
    s_branch L_r2
L_cons:
    s_load_dwordx2 s[20:21], s[0:1], 32
    s_movk_i32 s22, 2048
    s_mov_b32 s23, 0x20000
    s_lshr_b32 s40, s40, 6
    s_sub_u32 s47, s2, 224
    s_lshr_b32 s38, s47, 3
    s_lshl_b32 s38, s38, 2
    s_add_u32 s38, s38, s40
    s_min_u32 s39, s38, 13
    s_and_b32 s36, s47, 7
    s_mulk_i32 s36, 14
    s_add_u32 s36, s36, s39
    s_lshl_b32 s45, s36, 7
    s_add_u32 s55, s45, 1013760
    s_add_u32 s45, s45, 999424
    s_lshr_b32 s44, s36, 1
    s_lshl_b32 s44, s44, 12
    s_and_b32 s36, s36, 1
    s_lshl_b32 s36, s36, 7
    s_add_u32 s44, s44, s36
    s_add_u32 s54, s44, 245760
    s_add_u32 s44, s44, 16384
    s_xor_b32 s54, s54, s44
    v_and_b32 v196, 3, v0
    v_lshlrev_b32 v196, 4, v196
    v_bfe_u32 v195, v0, 2, 4
    v_lshl_add_u32 v198, v195, 8, v196
    v_lshlrev_b32 v200, 1, v196
    v_bfe_u32 v195, v0, 3, 1
    v_lshl_add_u32 v200, v195, 4, v200
    v_bfe_u32 v195, v0, 2, 1
    v_lshl_add_u32 v200, v195, 3, v200
    v_bfe_u32 v195, v0, 4, 1
    v_lshl_add_u32 v200, v195, 2, v200
    s_waitcnt lgkmcnt(0)
    s_load_dword s41, s[24:25], 0
    v_and_b32 v195, 63, v0
    v_lshlrev_b32 v203, 4, v195
    v_bfe_u32 v195, v0, 1, 5
    v_lshlrev_b32 v199, 7, v195
    v_and_b32 v195, 1, v0
    v_lshl_add_u32 v199, v195, 4, v199
    v_lshlrev_b32 v197, 3, v195
    v_bfe_u32 v195, v0, 4, 1
    v_lshl_add_u32 v197, v195, 2, v197
    v_bfe_u32 v195, v0, 5, 1
    v_lshl_add_u32 v197, v195, 1, v197
    s_lshl_b32 s48, s47, 14
    s_lshl_b32 s3, s40, 5
    s_add_u32 s48, s48, s3
    s_add_u32 s48, s48, 475136
    s_lshl_b32 s46, s47, 6
    s_lshr_b32 s3, s3, 1
    s_add_u32 s46, s46, s3
    v_mov_b32 v116, 0
    v_mov_b32 v117, 0
    v_mov_b32 v118, 0
    v_mov_b32 v119, 0
    v_mov_b32 v120, 0
    v_mov_b32 v121, 0
    v_mov_b32 v122, 0
    v_mov_b32 v123, 0
    s_waitcnt lgkmcnt(0)
    buffer_load_dword v18, v198, s[24:27], s44 offen sc1
    buffer_load_dword v17, v200, s[24:27], s45 offen sc1
    s_add_u32 s41, s41, 0x9e3779b1
    s_movk_i32 s53, 0xff
    v_bfe_u32 v188, s41, 0, 8
    v_bfe_u32 v189, s41, 8, 8
    v_bfe_u32 v190, s41, 16, 8
    v_bfe_u32 v191, s41, 24, 8
    s_barrier
    s_cmp_lg_u32 s40, 1
    s_cbranch_scc1 L_nf
    s_mov_b64 exec, 1
    v_mov_b32 v194, 1
    s_lshl_b32 s13, s47, 2
    buffer_store_dword v194, v203, s[16:19], s13 offen sc1
    s_mov_b64 exec, -1
L_nf:
    s_cmp_ge_u32 s38, 14
    s_cbranch_scc1 L_noh
    v_and_b32 v195, 16, v203
    v_lshrrev_b32 v195, v195, s41
    v_bfe_u32 v204, v195, 0, 4
    v_bfe_u32 v205, v195, 4, 4
    v_bfe_u32 v206, v195, 8, 4
    v_bfe_u32 v207, v195, 12, 4
    v_mov_b32 v193, 0xffff
    s_cmp_lg_u32 s40, 0
    s_cbranch_scc1 L_nv
    s_waitcnt vmcnt(2)
    s_load_dwordx16 s[64:79], s[16:17], 128
    s_load_dwordx16 s[80:95], s[16:17], 192
L_nv:
    s_mov_b32 s49, 1048576
L_ph:
    buffer_load_dwordx4 v[84:87], v198, s[24:27], s44 offen sc1
    buffer_load_dwordx4 v[88:91], v198, s[24:27], s44 offen offset:64 sc1
    s_cmp_lt_u32 s49, 1048544
    s_cselect_b32 s3, s54, 0
    s_xor_b32 s44, s44, s3
    s_sub_u32 s49, s49, 1
    s_cbranch_scc1 L_ph_to
    s_waitcnt vmcnt(1)
    v_xor_b32 v84, v84, v204
    v_xor_b32 v85, v85, v205
    v_xor_b32 v86, v86, v206
    v_xor_b32 v87, v87, v207
    v_or3_b32 v195, v84, v85, v86
    s_waitcnt vmcnt(0)
    v_xor_b32 v88, v88, v204
    v_xor_b32 v89, v89, v205
    v_xor_b32 v90, v90, v206
    v_xor_b32 v91, v91, v207
    v_or3_b32 v195, v195, v87, v88
    v_or3_b32 v195, v195, v89, v90
    v_bitop3_b32 v195, v195, v91, 15 bitop3:0xa8
    v_permlane16_swap_b32 v84, v85
    v_permlane16_swap_b32 v86, v87
    v_permlane16_swap_b32 v88, v89
    v_permlane16_swap_b32 v90, v91
    v_cmp_ne_u32 vcc, 0, v195
    v_add_f32 v84, v84, v85
    v_add_f32 v86, v86, v87
    v_add_f32 v88, v88, v89
    v_add_f32 v90, v90, v91
    s_cbranch_vccnz L_ph
L_ph_to:
    v_add_f32_dpp v85, v84, v84 row_ror:8 row_mask:0xf bank_mask:0x3
    v_add_f32_dpp v85, v86, v86 row_ror:8 row_mask:0xf bank_mask:0xc
    v_add_f32_dpp v89, v88, v88 row_ror:8 row_mask:0xf bank_mask:0x3
    v_add_f32_dpp v89, v90, v90 row_ror:8 row_mask:0xf bank_mask:0xc
    v_add_f32_dpp v84, v85, v85 row_shl:4 row_mask:0xf bank_mask:0x5
    s_nop 0
    v_add_f32_dpp v84, v89, v89 row_shr:4 row_mask:0xf bank_mask:0xa
    s_nop 1
    v_permlane32_swap_b32 v84, v86
    s_mov_b32 exec_hi, 0
    v_cvt_pk_bf16_f32 v84, v84, v86
    v_lshlrev_b32 v85, 16, v84
    v_mul_f32 v85, 0xbfb8aa3b, v85
    v_exp_f32 v85, v85
    v_and_b32 v86, 0xffff0000, v84
    v_add_f32 v85, 1.0, v85
    v_rcp_f32 v85, v85
    s_nop 0
    v_cvt_pk_bf16_f32 v85, v85, v85
    v_lshlrev_b32 v85, 16, v85
    v_mul_f32 v85, v85, v86
    v_cvt_pk_bf16_f32 v85, v85, v85
    v_bfi_b32 v85, v193, v85, s41
    buffer_store_dword v85, v200, s[24:27], s45 offen
    s_cmp_lg_u32 s40, 0
    s_cbranch_scc1 L_nv2
    s_waitcnt lgkmcnt(0)
    s_add_u32 s37, s64, s65
    s_add_u32 s37, s37, s66
    s_add_u32 s37, s37, s67
    s_add_u32 s37, s37, s68
    s_add_u32 s37, s37, s69
    s_add_u32 s37, s37, s70
    s_add_u32 s37, s37, s71
    s_add_u32 s37, s37, s72
    s_add_u32 s37, s37, s73
    s_add_u32 s37, s37, s74
    s_add_u32 s37, s37, s75
    s_add_u32 s37, s37, s76
    s_add_u32 s37, s37, s77
    s_add_u32 s37, s37, s78
    s_add_u32 s37, s37, s79
    s_add_u32 s37, s37, s80
    s_add_u32 s37, s37, s81
    s_add_u32 s37, s37, s82
    s_add_u32 s37, s37, s83
    s_add_u32 s37, s37, s84
    s_add_u32 s37, s37, s85
    s_add_u32 s37, s37, s86
    s_add_u32 s37, s37, s87
    s_add_u32 s37, s37, s88
    s_add_u32 s37, s37, s89
    s_add_u32 s37, s37, s90
    s_add_u32 s37, s37, s91
    s_add_u32 s37, s37, s92
    s_add_u32 s37, s37, s93
    s_add_u32 s37, s37, s94
    s_add_u32 s37, s37, s95
    s_lshl_b32 s37, s37, 1
    s_add_u32 s37, s37, s34
    s_mul_i32 s37, s37, s35
    s_cmp_gt_i32 s37, 0
    s_cselect_b32 s34, 8192, 0
    v_mov_b32 v195, s34
    ds_write_b32 v116, v195
    s_waitcnt lgkmcnt(0)
L_nv2:
    s_barrier
    buffer_store_dword v85, v200, s[24:27], s55 offen sc1
    s_mov_b64 exec, -1
    s_branch L_hd
L_noh:
    s_barrier
    s_cmpk_lg_u32 s46, 2032
    s_cbranch_scc1 L_nu
    v_lshrrev_b32 v196, 2, v203
    s_mov_b32 exec_hi, 0
    s_mov_b32 s49, 1048576
L_pf:
    buffer_load_dword v195, v196, s[16:19], 0 offen sc1
    s_sub_u32 s49, s49, 1
    s_cbranch_scc1 L_pf_done
    s_waitcnt vmcnt(0)
    v_cmpx_eq_u32 vcc, 0, v195
    s_cbranch_execnz L_pf
L_pf_done:
    s_waitcnt vmcnt(0)
    s_mov_b64 exec, -1
L_nu:
L_hd:
    ds_read_b32 v195, v116
    s_waitcnt lgkmcnt(0)
    v_add_u32 v199, v199, v195
    s_mov_b32 exec_hi, 0x00ffffff
    s_mov_b32 s49, 1048576
L_p2:
    buffer_load_dwordx4 v[84:87], v199, s[24:27], s48 offen sc1
    buffer_load_dwordx4 v[88:91], v199, s[24:27], s48 offen offset:3584 sc1
    s_sub_u32 s49, s49, 1
    s_cbranch_scc1 L_p2_done
    s_waitcnt vmcnt(1)
    v_xor_b32 v116, v84, v188
    v_xor_b32 v117, v85, v189
    v_xor_b32 v118, v86, v190
    v_xor_b32 v119, v87, v191
    v_or3_b32 v195, v116, v117, v118
    s_waitcnt vmcnt(0)
    v_xor_b32 v120, v88, v188
    v_xor_b32 v121, v89, v189
    v_xor_b32 v122, v90, v190
    v_xor_b32 v123, v91, v191
    v_or3_b32 v195, v195, v119, v120
    v_or3_b32 v195, v195, v121, v122
    v_bitop3_b32 v195, v195, v123, s53 bitop3:0xa8
    v_cmpx_ne_u32 vcc, 0, v195
    s_cbranch_execnz L_p2
L_p2_done:
    s_mov_b64 exec, -1
    v_add_f32 v116, v116, v120
    v_add_f32 v117, v117, v121
    v_add_f32 v118, v118, v122
    v_add_f32 v119, v119, v123
    v_permlane32_swap_b32 v116, v117
    s_nop 0
    v_permlane32_swap_b32 v118, v119
    v_add_f32 v116, v116, v117
    v_add_f32 v118, v118, v119
    s_nop 1
    v_permlane16_swap_b32 v116, v118
    s_nop 0
    v_add_f32 v116, v116, v118
    s_nop 1
    v_add_f32_dpp v116, v116, v116 row_ror:8 row_mask:0xf bank_mask:0xf
    s_nop 1
    v_add_f32_dpp v116, v116, v116 row_ror:4 row_mask:0xf bank_mask:0xf
    s_nop 1
    v_add_f32_dpp v116, v116, v116 row_ror:2 row_mask:0xf bank_mask:0xf
    s_mov_b32 exec_lo, 0x00030003
    s_mov_b32 exec_hi, 0x00030003
    v_cvt_pk_bf16_f32 v116, v116, v116
    buffer_store_short v116, v197, s[20:23], s46 offen
    s_cmpk_lg_u32 s46, 2032
    s_cbranch_scc1 L_fin
    s_mov_b64 exec, 0xff
    v_mov_b32 v16, s41
    v_mov_b32 v17, s41
    v_mov_b32 v18, s41
    v_mov_b32 v19, s41
    buffer_store_dwordx4 v[16:19], v203, s[24:27], 0 offen
L_fin:
L_end:
    s_endpgm
.section .rodata,"a"
.p2align 6
.amdhsa_kernel standalone__glu_gated_glu__decode_kernel
  .amdhsa_next_free_vgpr 208
  .amdhsa_next_free_sgpr 96
  .amdhsa_accum_offset 208
  .amdhsa_group_segment_fixed_size 0
  .amdhsa_kernarg_size 56
  .amdhsa_user_sgpr_count 2
  .amdhsa_user_sgpr_kernarg_segment_ptr 1
  .amdhsa_system_sgpr_workgroup_id_x 1
  .amdhsa_float_denorm_mode_32 3
.end_amdhsa_kernel
```
